```python
import torch

def _softmax(x, axis=-1):
    return torch.softmax(x, dim=axis)
def _gelu(x):
    return torch.nn.functional.gelu(x, approximate="tanh")
def _silu(x):
    return torch.nn.functional.silu(x)
def _sigmoid(x):
    return torch.sigmoid(x)
def _layernorm(x, axis=-1, eps=1e-5):
    m = x.mean(dim=axis, keepdim=True)
    v = x.var(dim=axis, keepdim=True, unbiased=False)
    return (x - m) / torch.sqrt(v + eps)
def _scatter_add(tgt, idx, src, axis=0):
    return tgt.clone().index_add_(axis, idx, src)
def _segment_sum(src, seg, n):
    out = torch.zeros((n,) + src.shape[1:], dtype=src.dtype)
    return out.index_add_(0, seg, src)
def _pad(x, pw):
    flat = tuple(v for pair in reversed(pw) for v in pair)
    return torch.nn.functional.pad(x, flat)

kernel_name = 'concat_heads__sliding_block_cached__sliding_block_cached__decode'

def setup_inputs():

    _w = (lambda a: (lambda t: t.to(torch.bfloat16) if t.is_floating_point() else t)(torch.as_tensor(a)))
    def _A_setup():
        B, Sq, D = 8, 1, 512
        Hq, Hkv, Sk, Dh = 32, 8, 4096, 128
        assert Hq % Hkv == 0, (Hq, Hkv)
        return {
            "x": _w((lambda *s: torch.randn(*s, dtype=torch.bfloat16) * 0.8)(B, Sq, D)),
            "k_cache": _w((lambda *s: torch.randn(*s, dtype=torch.bfloat16) * 0.8)(B, Hkv, Sk, Dh)),
            "v_cache": _w((lambda *s: torch.randn(*s, dtype=torch.bfloat16) * 0.05)(B, Hkv, Sk, Dh)),
            "wq": _w((lambda *s: torch.randn(*s, dtype=torch.bfloat16) * 0.8)(D, Hq * Dh) * (D ** -0.5)),
            "wo": _w((lambda *s: torch.randn(*s, dtype=torch.bfloat16) * 0.05)(Hq * Dh, D) * ((Hq * Dh) ** -0.5)),
        }
    _A_in = _A_setup()

    def _B_setup():
        B, Sq, D = 8, 1, 512
        Hq, Hkv, Sk, Dh = 32, 8, 4096, 128
        assert Hq % Hkv == 0, (Hq, Hkv)
        return {
            "x": _w((lambda *s: torch.randn(*s, dtype=torch.bfloat16) * 0.8)(B, Sq, D)),
            "k_cache": _w((lambda *s: torch.randn(*s, dtype=torch.bfloat16) * 0.8)(B, Hkv, Sk, Dh)),
            "v_cache": _w((lambda *s: torch.randn(*s, dtype=torch.bfloat16) * 0.05)(B, Hkv, Sk, Dh)),
            "wq": _w((lambda *s: torch.randn(*s, dtype=torch.bfloat16) * 0.8)(D, Hq * Dh) * (D ** -0.5)),
            "wo": _w((lambda *s: torch.randn(*s, dtype=torch.bfloat16) * 0.05)(Hq * Dh, D) * ((Hq * Dh) ** -0.5)),
        }
    _B_in = _B_setup()

    return {
        "A_x": _A_in["x"],
        "A_k_cache": _A_in["k_cache"],
        "A_v_cache": _A_in["v_cache"],
        "A_wq": _A_in["wq"],
        "A_wo": _A_in["wo"],
        "B_x": _B_in["x"],
        "B_k_cache": _B_in["k_cache"],
        "B_v_cache": _B_in["v_cache"],
        "B_wq": _B_in["wq"],
        "B_wo": _B_in["wo"],
    }

def reference(A_x, A_k_cache, A_v_cache, A_wq, A_wo, B_x, B_k_cache, B_v_cache, B_wq, B_wo):
    def _A_ref(x, k_cache, v_cache, wq, wo):
        B, Sq, D = x.shape
        Hq, Dh = 32, 128
        Hkv, Sk = k_cache.shape[1], k_cache.shape[2]
        W = min(4096, max(256, Sk // 4))
        rep = Hq // Hkv
        q = (lambda x, *d: x.permute(*d))((x @ wq).reshape(B, Sq, Hq, Dh), 0, 2, 1, 3)
        k = (lambda x, n, axis: torch.repeat_interleave(x, n, dim=axis))(k_cache[:, :, Sk - W:, :], rep, axis=1)
        v = (lambda x, n, axis: torch.repeat_interleave(x, n, dim=axis))(v_cache[:, :, Sk - W:, :], rep, axis=1)
        scores = torch.einsum("bhqd,bhkd->bhqk", q, k) * (Dh ** -0.5)
        p = _softmax(scores, axis=-1)
        o = torch.einsum("bhqk,bhkd->bhqd", p, v)
        return (lambda x, *d: x.permute(*d))(o, 0, 2, 1, 3).reshape(B, Sq, Hq * Dh) @ wo

    def _B_ref(x, k_cache, v_cache, wq, wo):
        B, Sq, D = x.shape
        Hq, Dh = 32, 128
        Hkv, Sk = k_cache.shape[1], k_cache.shape[2]
        W = min(4096, max(256, Sk // 4))
        rep = Hq // Hkv
        q = (lambda x, *d: x.permute(*d))((x @ wq).reshape(B, Sq, Hq, Dh), 0, 2, 1, 3)
        k = (lambda x, n, axis: torch.repeat_interleave(x, n, dim=axis))(k_cache[:, :, Sk - W:, :], rep, axis=1)
        v = (lambda x, n, axis: torch.repeat_interleave(x, n, dim=axis))(v_cache[:, :, Sk - W:, :], rep, axis=1)
        scores = torch.einsum("bhqd,bhkd->bhqk", q, k) * (Dh ** -0.5)
        p = _softmax(scores, axis=-1)
        o = torch.einsum("bhqk,bhkd->bhqd", p, v)
        return (lambda x, *d: x.permute(*d))(o, 0, 2, 1, 3).reshape(B, Sq, Hq * Dh) @ wo

    a = _A_ref(A_x, A_k_cache, A_v_cache, A_wq, A_wo)
    b = _B_ref(B_x, B_k_cache, B_v_cache, B_wq, B_wo)
    return torch.concatenate([a, b], axis=-1)
```

```asm
; @launch grid=(256,1,1) block=(512,1,1) lds=157312
.amdgcn_target "amdgcn-amd-amdhsa--gfx950"
.text
.globl concat_heads__sliding_block_cached__sliding_block_cached__decode_kernel
.p2align 8
.type concat_heads__sliding_block_cached__sliding_block_cached__decode_kernel,@function
concat_heads__sliding_block_cached__sliding_block_cached__decode_kernel:
    s_cmp_ge_u32 s2, 256
    s_cbranch_scc1 L_end
    s_lshr_b32 s4, s2, 7
    s_mul_i32 s5, s4, 40
    s_add_u32 s6, s0, s5
    s_addc_u32 s7, s1, 0
    s_load_dwordx4 s[8:11], s[6:7], 8
    s_load_dwordx4 s[12:15], s[6:7], 24
    v_lshrrev_b32 v1, 6, v0
    v_and_b32 v0, 63, v0
    s_bfe_u32 s26, s2, 0x30004
    v_readfirstlane_b32 s3, v1
    s_bfe_u32 s27, s2, 0x30001
    s_and_b32 s28, s2, 1
    v_lshrrev_b32 v2, 4, v0
    v_and_b32 v3, 15, v0
    s_and_b32 s31, s3, 3
    s_cmp_lt_u32 s3, 4
    s_cbranch_scc1 L_aux
    s_load_dwordx2 s[40:41], s[0:1], 96
    s_mov_b32 s34, 0x4000000
    s_mov_b32 s35, 0x20000
    s_lshl_b32 s56, s27, 23
    s_lshl_b32 s57, s26, 20
    s_add_u32 s56, s56, s57
    s_lshl_b32 s57, s28, 17
    s_add_u32 s56, s56, s57
    s_lshl_b32 s57, s31, 15
    s_add_u32 s56, s56, s57
    s_add_u32 s56, s56, 786432
    v_lshlrev_b32 v12, 2, v2
    v_lshlrev_b32 v13, 8, v2
    v_add_u32 v14, 0, v12
    v_xor_b32 v14, v14, v3
    v_lshl_add_u32 v8, v14, 4, v13
    v_add_u32 v14, 1, v12
    v_xor_b32 v14, v14, v3
    v_lshl_add_u32 v9, v14, 4, v13
    v_add_u32 v14, 2, v12
    v_xor_b32 v14, v14, v3
    v_lshl_add_u32 v10, v14, 4, v13
    v_add_u32 v14, 3, v12
    v_xor_b32 v14, v14, v3
    v_lshl_add_u32 v11, v14, 4, v13
    s_mul_i32 s61, s2, 13
    s_lshl_b32 s62, s31, 3
    s_add_u32 s61, s61, s62
    s_lshl_b32 s61, s61, 10
    s_waitcnt lgkmcnt(0)
    s_mov_b32 s32, s8
    s_mov_b32 s33, s9
    s_add_u32 m0, s57, 0
    s_add_u32 s58, s61, 0
    s_and_b32 s58, s58, 31744
    s_add_u32 s58, s58, s56
    buffer_load_dwordx4 v8, s[32:35], s58 offen nt lds
    s_add_u32 m0, s57, 1024
    s_add_u32 s58, s61, 1024
    s_and_b32 s58, s58, 31744
    s_add_u32 s58, s58, s56
    buffer_load_dwordx4 v9, s[32:35], s58 offen nt lds
    s_add_u32 m0, s57, 2048
    s_add_u32 s58, s61, 2048
    s_and_b32 s58, s58, 31744
    s_add_u32 s58, s58, s56
    buffer_load_dwordx4 v10, s[32:35], s58 offen nt lds
    s_add_u32 m0, s57, 3072
    s_add_u32 s58, s61, 3072
    s_and_b32 s58, s58, 31744
    s_add_u32 s58, s58, s56
    buffer_load_dwordx4 v11, s[32:35], s58 offen nt lds
    s_add_u32 m0, s57, 4096
    s_add_u32 s58, s61, 4096
    s_and_b32 s58, s58, 31744
    s_add_u32 s58, s58, s56
    buffer_load_dwordx4 v8, s[32:35], s58 offen nt lds
    s_add_u32 m0, s57, 5120
    s_add_u32 s58, s61, 5120
    s_and_b32 s58, s58, 31744
    s_add_u32 s58, s58, s56
    s_and_b32 s29, s2, 15
    s_lshr_b32 s30, s2, 4
    s_lshr_b32 s53, s29, 2
    s_and_b32 s54, s29, 3
    s_mov_b32 s48, 0x05040100
    s_mov_b32 s49, 0x07060302
    s_mov_b32 s52, 4194304
    v_mov_b32 v1, 156928
    v_mov_b32 v4, 1
    v_lshlrev_b32 v5, 4, v0
    s_lshl_b32 s55, s31, 2
    v_add_u32 v6, s55, v1
    s_mov_b32 s42, 3145728
    s_mov_b32 s43, 0x20000
    s_mov_b32 s36, s10
    s_mov_b32 s37, s11
    s_mov_b32 s38, 0x4000000
    s_mov_b32 s39, 0x20000
    s_barrier
    s_waitcnt vmcnt(4)
    buffer_load_dwordx4 v9, s[32:35], s58 offen nt lds
    s_add_u32 m0, s57, 6144
    s_add_u32 s58, s61, 6144
    s_and_b32 s58, s58, 31744
    s_add_u32 s58, s58, s56
    s_waitcnt vmcnt(4)
    buffer_load_dwordx4 v10, s[32:35], s58 offen nt lds
    s_add_u32 m0, s57, 7168
    s_add_u32 s58, s61, 7168
    s_and_b32 s58, s58, 31744
    s_add_u32 s58, s58, s56
    s_waitcnt vmcnt(4)
    buffer_load_dwordx4 v11, s[32:35], s58 offen nt lds
    s_add_u32 m0, s57, 8192
    s_add_u32 s58, s61, 8192
    s_and_b32 s58, s58, 31744
    s_add_u32 s58, s58, s56
    s_waitcnt vmcnt(4)
    buffer_load_dwordx4 v8, s[32:35], s58 offen nt lds
    s_add_u32 m0, s57, 9216
    s_add_u32 s58, s61, 9216
    s_and_b32 s58, s58, 31744
    s_add_u32 s58, s58, s56
    s_waitcnt vmcnt(4)
    buffer_load_dwordx4 v9, s[32:35], s58 offen nt lds
    s_add_u32 m0, s57, 10240
    s_add_u32 s58, s61, 10240
    s_and_b32 s58, s58, 31744
    s_add_u32 s58, s58, s56
    s_waitcnt vmcnt(4)
    buffer_load_dwordx4 v10, s[32:35], s58 offen nt lds
    s_add_u32 m0, s57, 11264
    s_add_u32 s58, s61, 11264
    s_and_b32 s58, s58, 31744
    s_add_u32 s58, s58, s56
    s_waitcnt vmcnt(4)
    buffer_load_dwordx4 v11, s[32:35], s58 offen nt lds
    s_add_u32 m0, s57, 12288
    s_add_u32 s58, s61, 12288
    s_and_b32 s58, s58, 31744
    s_add_u32 s58, s58, s56
    s_waitcnt vmcnt(4)
    buffer_load_dwordx4 v8, s[32:35], s58 offen nt lds
    s_add_u32 m0, s57, 13312
    s_add_u32 s58, s61, 13312
    s_and_b32 s58, s58, 31744
    s_add_u32 s58, s58, s56
    s_waitcnt vmcnt(4)
    buffer_load_dwordx4 v9, s[32:35], s58 offen nt lds
    s_add_u32 m0, s57, 14336
    s_add_u32 s58, s61, 14336
    s_and_b32 s58, s58, 31744
    s_add_u32 s58, s58, s56
    s_waitcnt vmcnt(4)
    buffer_load_dwordx4 v10, s[32:35], s58 offen nt lds
    s_add_u32 m0, s57, 15360
    s_add_u32 s58, s61, 15360
    s_and_b32 s58, s58, 31744
    s_add_u32 s58, s58, s56
    s_waitcnt vmcnt(4)
    buffer_load_dwordx4 v11, s[32:35], s58 offen nt lds
    s_add_u32 m0, s57, 16384
    s_add_u32 s58, s61, 16384
    s_and_b32 s58, s58, 31744
    s_add_u32 s58, s58, s56
    s_waitcnt vmcnt(4)
    buffer_load_dwordx4 v8, s[32:35], s58 offen nt lds
    s_add_u32 m0, s57, 17408
    s_add_u32 s58, s61, 17408
    s_and_b32 s58, s58, 31744
    s_add_u32 s58, s58, s56
    s_waitcnt vmcnt(4)
    buffer_load_dwordx4 v9, s[32:35], s58 offen nt lds
    s_add_u32 m0, s57, 18432
    s_add_u32 s58, s61, 18432
    s_and_b32 s58, s58, 31744
    s_add_u32 s58, s58, s56
    s_waitcnt vmcnt(4)
    buffer_load_dwordx4 v10, s[32:35], s58 offen nt lds
    s_add_u32 m0, s57, 19456
    s_add_u32 s58, s61, 19456
    s_and_b32 s58, s58, 31744
    s_add_u32 s58, s58, s56
    s_waitcnt vmcnt(4)
    buffer_load_dwordx4 v11, s[32:35], s58 offen nt lds
    s_add_u32 m0, s57, 20480
    s_add_u32 s58, s61, 20480
    s_and_b32 s58, s58, 31744
    s_add_u32 s58, s58, s56
    s_waitcnt vmcnt(4)
    buffer_load_dwordx4 v8, s[32:35], s58 offen nt lds
    s_add_u32 m0, s57, 21504
    s_add_u32 s58, s61, 21504
    s_and_b32 s58, s58, 31744
    s_add_u32 s58, s58, s56
    s_waitcnt vmcnt(4)
    buffer_load_dwordx4 v9, s[32:35], s58 offen nt lds
    s_add_u32 m0, s57, 22528
    s_add_u32 s58, s61, 22528
    s_and_b32 s58, s58, 31744
    s_add_u32 s58, s58, s56
    s_waitcnt vmcnt(4)
    buffer_load_dwordx4 v10, s[32:35], s58 offen nt lds
    s_add_u32 m0, s57, 23552
    s_add_u32 s58, s61, 23552
    s_and_b32 s58, s58, 31744
    s_add_u32 s58, s58, s56
    s_waitcnt vmcnt(4)
    buffer_load_dwordx4 v11, s[32:35], s58 offen nt lds
    s_add_u32 m0, s57, 24576
    s_add_u32 s58, s61, 24576
    s_and_b32 s58, s58, 31744
    s_add_u32 s58, s58, s56
    s_waitcnt vmcnt(4)
    buffer_load_dwordx4 v8, s[32:35], s58 offen nt lds
    s_add_u32 m0, s57, 25600
    s_add_u32 s58, s61, 25600
    s_and_b32 s58, s58, 31744
    s_add_u32 s58, s58, s56
    s_waitcnt vmcnt(4)
    buffer_load_dwordx4 v9, s[32:35], s58 offen nt lds
    s_add_u32 m0, s57, 26624
    s_add_u32 s58, s61, 26624
    s_and_b32 s58, s58, 31744
    s_add_u32 s58, s58, s56
    s_waitcnt vmcnt(4)
    buffer_load_dwordx4 v10, s[32:35], s58 offen nt lds
    s_add_u32 m0, s57, 27648
    s_add_u32 s58, s61, 27648
    s_and_b32 s58, s58, 31744
    s_add_u32 s58, s58, s56
    s_waitcnt vmcnt(4)
    buffer_load_dwordx4 v11, s[32:35], s58 offen nt lds
    s_add_u32 m0, s57, 28672
    s_add_u32 s58, s61, 28672
    s_and_b32 s58, s58, 31744
    s_add_u32 s58, s58, s56
    s_waitcnt vmcnt(4)
    buffer_load_dwordx4 v8, s[32:35], s58 offen nt lds
    s_add_u32 m0, s57, 29696
    s_add_u32 s58, s61, 29696
    s_and_b32 s58, s58, 31744
    s_add_u32 s58, s58, s56
    s_waitcnt vmcnt(4)
    buffer_load_dwordx4 v9, s[32:35], s58 offen nt lds
    s_add_u32 m0, s57, 30720
    s_add_u32 s58, s61, 30720
    s_and_b32 s58, s58, 31744
    s_add_u32 s58, s58, s56
    s_waitcnt vmcnt(4)
    buffer_load_dwordx4 v10, s[32:35], s58 offen nt lds
    s_add_u32 m0, s57, 31744
    s_add_u32 s58, s61, 31744
    s_and_b32 s58, s58, 31744
    s_add_u32 s58, s58, s56
    s_waitcnt vmcnt(4)
    buffer_load_dwordx4 v11, s[32:35], s58 offen nt lds
    s_add_u32 s58, s61, 0
    s_and_b32 s58, s58, 31744
    s_add_u32 s58, s58, s56
    s_waitcnt vmcnt(4)
    buffer_load_dwordx4 v[64:67], v5, s[36:39], s58 offen nt
    s_add_u32 s58, s61, 1024
    s_and_b32 s58, s58, 31744
    s_add_u32 s58, s58, s56
    s_waitcnt vmcnt(4)
    buffer_load_dwordx4 v[68:71], v5, s[36:39], s58 offen nt
    s_add_u32 s58, s61, 2048
    s_and_b32 s58, s58, 31744
    s_add_u32 s58, s58, s56
    s_waitcnt vmcnt(4)
    buffer_load_dwordx4 v[72:75], v5, s[36:39], s58 offen nt
    s_add_u32 s58, s61, 3072
    s_and_b32 s58, s58, 31744
    s_add_u32 s58, s58, s56
    s_waitcnt vmcnt(4)
    buffer_load_dwordx4 v[76:79], v5, s[36:39], s58 offen nt
    s_add_u32 s58, s61, 4096
    s_and_b32 s58, s58, 31744
    s_add_u32 s58, s58, s56
    s_waitcnt vmcnt(4)
    ds_write_b32 v6, v4 offset:48
    buffer_load_dwordx4 v[80:83], v5, s[36:39], s58 offen nt
    s_add_u32 s58, s61, 5120
    s_and_b32 s58, s58, 31744
    s_add_u32 s58, s58, s56
    s_waitcnt vmcnt(4)
    buffer_load_dwordx4 v[84:87], v5, s[36:39], s58 offen nt
    s_add_u32 s58, s61, 6144
    s_and_b32 s58, s58, 31744
    s_add_u32 s58, s58, s56
    s_waitcnt vmcnt(4)
    buffer_load_dwordx4 v[88:91], v5, s[36:39], s58 offen nt
    s_add_u32 s58, s61, 7168
    s_and_b32 s58, s58, 31744
    s_add_u32 s58, s58, s56
    s_waitcnt vmcnt(4)
    buffer_load_dwordx4 v[92:95], v5, s[36:39], s58 offen nt
    s_add_u32 s58, s61, 8192
    s_and_b32 s58, s58, 31744
    s_add_u32 s58, s58, s56
    s_waitcnt vmcnt(9)
    buffer_load_dwordx4 v[96:99], v5, s[36:39], s58 offen nt
    s_add_u32 s58, s61, 9216
    s_and_b32 s58, s58, 31744
    s_add_u32 s58, s58, s56
    s_waitcnt vmcnt(9)
    buffer_load_dwordx4 v[100:103], v5, s[36:39], s58 offen nt
    s_add_u32 s58, s61, 10240
    s_and_b32 s58, s58, 31744
    s_add_u32 s58, s58, s56
    s_waitcnt vmcnt(9)
    buffer_load_dwordx4 v[104:107], v5, s[36:39], s58 offen nt
    s_add_u32 s58, s61, 11264
    s_and_b32 s58, s58, 31744
    s_add_u32 s58, s58, s56
    s_waitcnt vmcnt(9)
    buffer_load_dwordx4 v[108:111], v5, s[36:39], s58 offen nt
    s_add_u32 s58, s61, 12288
    s_and_b32 s58, s58, 31744
    s_add_u32 s58, s58, s56
    s_waitcnt vmcnt(9)
    buffer_load_dwordx4 v[112:115], v5, s[36:39], s58 offen nt
    s_add_u32 s58, s61, 13312
    s_and_b32 s58, s58, 31744
    s_add_u32 s58, s58, s56
    s_waitcnt vmcnt(9)
    buffer_load_dwordx4 v[116:119], v5, s[36:39], s58 offen nt
    s_add_u32 s58, s61, 14336
    s_and_b32 s58, s58, 31744
    s_add_u32 s58, s58, s56
    s_waitcnt vmcnt(9)
    buffer_load_dwordx4 v[120:123], v5, s[36:39], s58 offen nt
    s_add_u32 s58, s61, 15360
    s_and_b32 s58, s58, 31744
    s_add_u32 s58, s58, s56
    s_waitcnt vmcnt(9)
    buffer_load_dwordx4 v[124:127], v5, s[36:39], s58 offen nt
    s_add_u32 s58, s61, 16384
    s_and_b32 s58, s58, 31744
    s_add_u32 s58, s58, s56
    s_waitcnt vmcnt(9)
    buffer_load_dwordx4 v[128:131], v5, s[36:39], s58 offen nt
    s_add_u32 s58, s61, 17408
    s_and_b32 s58, s58, 31744
    s_add_u32 s58, s58, s56
    s_waitcnt vmcnt(9)
    buffer_load_dwordx4 v[132:135], v5, s[36:39], s58 offen nt
    s_add_u32 s58, s61, 18432
    s_and_b32 s58, s58, 31744
    s_add_u32 s58, s58, s56
    s_waitcnt vmcnt(9)
    buffer_load_dwordx4 v[136:139], v5, s[36:39], s58 offen nt
    s_add_u32 s58, s61, 19456
    s_and_b32 s58, s58, 31744
    s_add_u32 s58, s58, s56
    s_waitcnt vmcnt(9)
    buffer_load_dwordx4 v[140:143], v5, s[36:39], s58 offen nt
    s_add_u32 s58, s61, 20480
    s_and_b32 s58, s58, 31744
    s_add_u32 s58, s58, s56
    s_waitcnt vmcnt(9)
    buffer_load_dwordx4 v[144:147], v5, s[36:39], s58 offen nt
    s_add_u32 s58, s61, 21504
    s_and_b32 s58, s58, 31744
    s_add_u32 s58, s58, s56
    s_waitcnt vmcnt(9)
    buffer_load_dwordx4 v[148:151], v5, s[36:39], s58 offen nt
    s_add_u32 s58, s61, 22528
    s_and_b32 s58, s58, 31744
    s_add_u32 s58, s58, s56
    s_waitcnt vmcnt(9)
    buffer_load_dwordx4 v[152:155], v5, s[36:39], s58 offen nt
    s_add_u32 s58, s61, 23552
    s_and_b32 s58, s58, 31744
    s_add_u32 s58, s58, s56
    s_waitcnt vmcnt(9)
    buffer_load_dwordx4 v[156:159], v5, s[36:39], s58 offen nt
    s_add_u32 s58, s61, 24576
    s_and_b32 s58, s58, 31744
    s_add_u32 s58, s58, s56
    s_waitcnt vmcnt(9)
    buffer_load_dwordx4 v[160:163], v5, s[36:39], s58 offen nt
    s_add_u32 s58, s61, 25600
    s_and_b32 s58, s58, 31744
    s_add_u32 s58, s58, s56
    s_waitcnt vmcnt(9)
    buffer_load_dwordx4 v[164:167], v5, s[36:39], s58 offen nt
    s_add_u32 s58, s61, 26624
    s_and_b32 s58, s58, 31744
    s_add_u32 s58, s58, s56
    s_waitcnt vmcnt(9)
    buffer_load_dwordx4 v[168:171], v5, s[36:39], s58 offen nt
    s_add_u32 s58, s61, 27648
    s_and_b32 s58, s58, 31744
    s_add_u32 s58, s58, s56
    s_waitcnt vmcnt(9)
    buffer_load_dwordx4 v[172:175], v5, s[36:39], s58 offen nt
    s_add_u32 s58, s61, 28672
    s_and_b32 s58, s58, 31744
    s_add_u32 s58, s58, s56
    s_waitcnt vmcnt(9)
    buffer_load_dwordx4 v[176:179], v5, s[36:39], s58 offen nt
    s_add_u32 s58, s61, 29696
    s_and_b32 s58, s58, 31744
    s_add_u32 s58, s58, s56
    s_waitcnt vmcnt(9)
    buffer_load_dwordx4 v[180:183], v5, s[36:39], s58 offen nt
    s_add_u32 s58, s61, 30720
    s_and_b32 s58, s58, 31744
    s_add_u32 s58, s58, s56
    s_waitcnt vmcnt(9)
    buffer_load_dwordx4 v[184:187], v5, s[36:39], s58 offen nt
    s_add_u32 s58, s61, 31744
    s_and_b32 s58, s58, 31744
    s_add_u32 s58, s58, s56
    s_waitcnt vmcnt(9)
    buffer_load_dwordx4 v[188:191], v5, s[36:39], s58 offen nt
Lw_1:
    ds_read_b32 v244, v6 offset:80
    s_waitcnt lgkmcnt(0)
    v_readfirstlane_b32 s55, v244
    s_cmp_eq_u32 s55, 1
    s_cbranch_scc1 Ld_2
    s_sub_u32 s52, s52, 1
    s_cbranch_scc1 L_end
    s_sleep 1
    s_branch Lw_1
Ld_2:
    s_lshl_b32 s55, s31, 12
    v_add_u32 v7, s55, v5
    v_add_u32 v7, 131072, v7
    ds_read_b128 v[48:51], v7 offset:0
    ds_read_b128 v[52:55], v7 offset:1024
    ds_read_b128 v[56:59], v7 offset:2048
    ds_read_b128 v[60:63], v7 offset:3072
    s_waitcnt vmcnt(24)
    v_perm_b32 v192, v68, v64, s48
    v_perm_b32 v196, v68, v64, s49
    v_perm_b32 v200, v69, v65, s48
    v_perm_b32 v204, v69, v65, s49
    v_perm_b32 v208, v70, v66, s48
    v_perm_b32 v212, v70, v66, s49
    v_perm_b32 v216, v71, v67, s48
    v_perm_b32 v220, v71, v67, s49
    v_perm_b32 v193, v76, v72, s48
    v_perm_b32 v197, v76, v72, s49
    v_perm_b32 v201, v77, v73, s48
    v_perm_b32 v205, v77, v73, s49
    v_perm_b32 v209, v78, v74, s48
    v_perm_b32 v213, v78, v74, s49
    v_perm_b32 v217, v79, v75, s48
    v_perm_b32 v221, v79, v75, s49
    v_perm_b32 v194, v84, v80, s48
    v_perm_b32 v198, v84, v80, s49
    v_perm_b32 v202, v85, v81, s48
    v_perm_b32 v206, v85, v81, s49
    v_perm_b32 v210, v86, v82, s48
    v_perm_b32 v214, v86, v82, s49
    v_perm_b32 v218, v87, v83, s48
    v_perm_b32 v222, v87, v83, s49
    v_perm_b32 v195, v92, v88, s48
    v_perm_b32 v199, v92, v88, s49
    v_perm_b32 v203, v93, v89, s48
    v_perm_b32 v207, v93, v89, s49
    v_perm_b32 v211, v94, v90, s48
    v_perm_b32 v215, v94, v90, s49
    v_perm_b32 v219, v95, v91, s48
    v_perm_b32 v223, v95, v91, s49
    s_waitcnt lgkmcnt(0)
    s_nop 1
    v_mfma_f32_16x16x32_bf16 v[16:19], v[48:51], v[192:195], 0
    v_mfma_f32_16x16x32_bf16 v[20:23], v[48:51], v[196:199], 0
    v_mfma_f32_16x16x32_bf16 v[24:27], v[48:51], v[200:203], 0
    v_mfma_f32_16x16x32_bf16 v[28:31], v[48:51], v[204:207], 0
    v_mfma_f32_16x16x32_bf16 v[32:35], v[48:51], v[208:211], 0
    v_mfma_f32_16x16x32_bf16 v[36:39], v[48:51], v[212:215], 0
    v_mfma_f32_16x16x32_bf16 v[40:43], v[48:51], v[216:219], 0
    v_mfma_f32_16x16x32_bf16 v[44:47], v[48:51], v[220:223], 0
    s_waitcnt vmcnt(16)
    v_perm_b32 v192, v100, v96, s48
    v_perm_b32 v196, v100, v96, s49
    v_perm_b32 v200, v101, v97, s48
    v_perm_b32 v204, v101, v97, s49
    v_perm_b32 v208, v102, v98, s48
    v_perm_b32 v212, v102, v98, s49
    v_perm_b32 v216, v103, v99, s48
    v_perm_b32 v220, v103, v99, s49
    v_perm_b32 v193, v108, v104, s48
    v_perm_b32 v197, v108, v104, s49
    v_perm_b32 v201, v109, v105, s48
    v_perm_b32 v205, v109, v105, s49
    v_perm_b32 v209, v110, v106, s48
    v_perm_b32 v213, v110, v106, s49
    v_perm_b32 v217, v111, v107, s48
    v_perm_b32 v221, v111, v107, s49
    v_perm_b32 v194, v116, v112, s48
    v_perm_b32 v198, v116, v112, s49
    v_perm_b32 v202, v117, v113, s48
    v_perm_b32 v206, v117, v113, s49
    v_perm_b32 v210, v118, v114, s48
    v_perm_b32 v214, v118, v114, s49
    v_perm_b32 v218, v119, v115, s48
    v_perm_b32 v222, v119, v115, s49
    v_perm_b32 v195, v124, v120, s48
    v_perm_b32 v199, v124, v120, s49
    v_perm_b32 v203, v125, v121, s48
    v_perm_b32 v207, v125, v121, s49
    v_perm_b32 v211, v126, v122, s48
    v_perm_b32 v215, v126, v122, s49
    v_perm_b32 v219, v127, v123, s48
    v_perm_b32 v223, v127, v123, s49
    s_nop 1
    v_mfma_f32_16x16x32_bf16 v[16:19], v[52:55], v[192:195], v[16:19]
    v_mfma_f32_16x16x32_bf16 v[20:23], v[52:55], v[196:199], v[20:23]
    v_mfma_f32_16x16x32_bf16 v[24:27], v[52:55], v[200:203], v[24:27]
    v_mfma_f32_16x16x32_bf16 v[28:31], v[52:55], v[204:207], v[28:31]
    v_mfma_f32_16x16x32_bf16 v[32:35], v[52:55], v[208:211], v[32:35]
    v_mfma_f32_16x16x32_bf16 v[36:39], v[52:55], v[212:215], v[36:39]
    v_mfma_f32_16x16x32_bf16 v[40:43], v[52:55], v[216:219], v[40:43]
    v_mfma_f32_16x16x32_bf16 v[44:47], v[52:55], v[220:223], v[44:47]
    s_waitcnt vmcnt(8)
    v_perm_b32 v192, v132, v128, s48
    v_perm_b32 v196, v132, v128, s49
    v_perm_b32 v200, v133, v129, s48
    v_perm_b32 v204, v133, v129, s49
    v_perm_b32 v208, v134, v130, s48
    v_perm_b32 v212, v134, v130, s49
    v_perm_b32 v216, v135, v131, s48
    v_perm_b32 v220, v135, v131, s49
    v_perm_b32 v193, v140, v136, s48
    v_perm_b32 v197, v140, v136, s49
    v_perm_b32 v201, v141, v137, s48
    v_perm_b32 v205, v141, v137, s49
    v_perm_b32 v209, v142, v138, s48
    v_perm_b32 v213, v142, v138, s49
    v_perm_b32 v217, v143, v139, s48
    v_perm_b32 v221, v143, v139, s49
    v_perm_b32 v194, v148, v144, s48
    v_perm_b32 v198, v148, v144, s49
    v_perm_b32 v202, v149, v145, s48
    v_perm_b32 v206, v149, v145, s49
    v_perm_b32 v210, v150, v146, s48
    v_perm_b32 v214, v150, v146, s49
    v_perm_b32 v218, v151, v147, s48
    v_perm_b32 v222, v151, v147, s49
    v_perm_b32 v195, v156, v152, s48
    v_perm_b32 v199, v156, v152, s49
    v_perm_b32 v203, v157, v153, s48
    v_perm_b32 v207, v157, v153, s49
    v_perm_b32 v211, v158, v154, s48
    v_perm_b32 v215, v158, v154, s49
    v_perm_b32 v219, v159, v155, s48
    v_perm_b32 v223, v159, v155, s49
    s_nop 1
    v_mfma_f32_16x16x32_bf16 v[16:19], v[56:59], v[192:195], v[16:19]
    v_mfma_f32_16x16x32_bf16 v[20:23], v[56:59], v[196:199], v[20:23]
    v_mfma_f32_16x16x32_bf16 v[24:27], v[56:59], v[200:203], v[24:27]
    v_mfma_f32_16x16x32_bf16 v[28:31], v[56:59], v[204:207], v[28:31]
    v_mfma_f32_16x16x32_bf16 v[32:35], v[56:59], v[208:211], v[32:35]
    v_mfma_f32_16x16x32_bf16 v[36:39], v[56:59], v[212:215], v[36:39]
    v_mfma_f32_16x16x32_bf16 v[40:43], v[56:59], v[216:219], v[40:43]
    v_mfma_f32_16x16x32_bf16 v[44:47], v[56:59], v[220:223], v[44:47]
    s_waitcnt vmcnt(6)
    v_perm_b32 v192, v164, v160, s48
    v_perm_b32 v196, v164, v160, s49
    v_perm_b32 v200, v165, v161, s48
    v_perm_b32 v204, v165, v161, s49
    v_perm_b32 v208, v166, v162, s48
    v_perm_b32 v212, v166, v162, s49
    v_perm_b32 v216, v167, v163, s48
    v_perm_b32 v220, v167, v163, s49
    s_waitcnt vmcnt(4)
    ds_write_b32 v6, v4 offset:64
    v_perm_b32 v193, v172, v168, s48
    v_perm_b32 v197, v172, v168, s49
    v_perm_b32 v201, v173, v169, s48
    v_perm_b32 v205, v173, v169, s49
    v_perm_b32 v209, v174, v170, s48
    v_perm_b32 v213, v174, v170, s49
    v_perm_b32 v217, v175, v171, s48
    v_perm_b32 v221, v175, v171, s49
    s_waitcnt vmcnt(2)
    v_perm_b32 v194, v180, v176, s48
    v_perm_b32 v198, v180, v176, s49
    v_perm_b32 v202, v181, v177, s48
    v_perm_b32 v206, v181, v177, s49
    v_perm_b32 v210, v182, v178, s48
    v_perm_b32 v214, v182, v178, s49
    v_perm_b32 v218, v183, v179, s48
    v_perm_b32 v222, v183, v179, s49
    s_waitcnt vmcnt(0)
    v_perm_b32 v195, v188, v184, s48
    v_perm_b32 v199, v188, v184, s49
    v_perm_b32 v203, v189, v185, s48
    v_perm_b32 v207, v189, v185, s49
    v_perm_b32 v211, v190, v186, s48
    v_perm_b32 v215, v190, v186, s49
    v_perm_b32 v219, v191, v187, s48
    v_perm_b32 v223, v191, v187, s49
    s_nop 1
    v_mfma_f32_16x16x32_bf16 v[16:19], v[60:63], v[192:195], v[16:19]
    v_mfma_f32_16x16x32_bf16 v[20:23], v[60:63], v[196:199], v[20:23]
    v_mfma_f32_16x16x32_bf16 v[24:27], v[60:63], v[200:203], v[24:27]
    v_mfma_f32_16x16x32_bf16 v[28:31], v[60:63], v[204:207], v[28:31]
    v_mfma_f32_16x16x32_bf16 v[32:35], v[60:63], v[208:211], v[32:35]
    v_mfma_f32_16x16x32_bf16 v[36:39], v[60:63], v[212:215], v[36:39]
    v_mfma_f32_16x16x32_bf16 v[40:43], v[60:63], v[216:219], v[40:43]
    v_mfma_f32_16x16x32_bf16 v[44:47], v[60:63], v[220:223], v[44:47]
    s_lshl_b32 s55, s31, 11
    v_add_u32 v7, s55, v5
    v_add_u32 v7, 147456, v7
    s_mov_b64 exec, 0xffff
    s_nop 4
    ds_write_b128 v7, v[16:19] offset:0
    ds_write_b128 v7, v[20:23] offset:256
    ds_write_b128 v7, v[24:27] offset:512
    ds_write_b128 v7, v[28:31] offset:768
    ds_write_b128 v7, v[32:35] offset:1024
    ds_write_b128 v7, v[36:39] offset:1280
    ds_write_b128 v7, v[40:43] offset:1536
    ds_write_b128 v7, v[44:47] offset:1792
    s_mov_b64 exec, -1
    s_waitcnt lgkmcnt(0)
    s_barrier
    s_cmp_ge_u32 s31, 2
    s_cbranch_scc1 L_end
    s_lshl_b32 s55, s31, 10
    v_add_u32 v7, s55, v5
    v_add_u32 v8, 147456, v7
    v_mov_b32 v9, 156800
    ds_read_b128 v[16:19], v8 offset:0
    ds_read_b128 v[32:35], v9 offset:0
    ds_read_b128 v[20:23], v8 offset:2048
    ds_read_b128 v[36:39], v9 offset:16
    ds_read_b128 v[24:27], v8 offset:4096
    ds_read_b128 v[40:43], v9 offset:32
    ds_read_b128 v[28:31], v8 offset:6144
    ds_read_b128 v[44:47], v9 offset:48
    s_lshl_b32 s55, s2, 10
    s_add_u32 s55, s55, 65536
    v_lshrrev_b32 v7, 1, v7
    s_waitcnt lgkmcnt(6)
    v_mul_f32 v48, v16, v32
    v_mul_f32 v49, v17, v33
    v_mul_f32 v50, v18, v34
    v_mul_f32 v51, v19, v35
    s_waitcnt lgkmcnt(4)
    v_fmac_f32 v48, v20, v36
    v_fmac_f32 v49, v21, v37
    v_fmac_f32 v50, v22, v38
    v_fmac_f32 v51, v23, v39
    s_waitcnt lgkmcnt(2)
    v_fmac_f32 v48, v24, v40
    v_fmac_f32 v49, v25, v41
    v_fmac_f32 v50, v26, v42
    v_fmac_f32 v51, v27, v43
    s_waitcnt lgkmcnt(0)
    v_fmac_f32 v48, v28, v44
    v_fmac_f32 v49, v29, v45
    v_fmac_f32 v50, v30, v46
    v_fmac_f32 v51, v31, v47
    v_cvt_pk_bf16_f32 v48, v48, v49
    v_cvt_pk_bf16_f32 v49, v50, v51
    v_min_u32 v48, -2, v48
    v_min_u32 v49, -2, v49
    buffer_store_dwordx2 v[48:49], v7, s[40:43], s55 offen sc1
    s_branch L_end
L_aux:
    s_setprio 3
    s_load_dwordx2 s[44:45], s[6:7], 0
    s_load_dwordx2 s[40:41], s[0:1], 96
    s_load_dwordx4 s[20:23], s[0:1], 80
    s_cmp_lg_u32 s31, 1
    s_cbranch_scc1 Lcw_3
    s_getpc_b64 s[56:57]
L_pc:
    s_sub_u32 s56, s56, L_pc - concat_heads__sliding_block_cached__sliding_block_cached__decode_kernel
    s_subb_u32 s57, s57, 0
    v_lshlrev_b32 v8, 7, v0
    v_cmp_gt_u32 vcc, L_code_end - concat_heads__sliding_block_cached__sliding_block_cached__decode_kernel, v8
    s_and_saveexec_b64 s[58:59], vcc
    global_load_dword v242, v8, s[56:57]
    v_add_u32 v8, 8192, v8
    v_cmp_gt_u32 vcc, L_code_end - concat_heads__sliding_block_cached__sliding_block_cached__decode_kernel, v8
    s_and_b64 exec, exec, vcc
    s_cbranch_execz Lcw_4
    global_load_dword v243, v8, s[56:57]
    v_add_u32 v8, 8192, v8
    v_cmp_gt_u32 vcc, L_code_end - concat_heads__sliding_block_cached__sliding_block_cached__decode_kernel, v8
    s_and_b64 exec, exec, vcc
    s_cbranch_execz Lcw_4
    global_load_dword v239, v8, s[56:57]
Lcw_4:
    s_mov_b64 exec, -1
Lcw_3:
    s_mov_b32 s34, 0x400000
    s_mov_b32 s35, 0x20000
    s_lshl_b32 s56, s28, 8
    s_lshl_b32 s57, s31, 6
    s_add_u32 s56, s56, s57
    s_lshl_b32 s57, s56, 13
    s_lshl_b32 s58, s26, 10
    s_add_u32 s57, s57, s58
    s_lshl_b32 s58, s27, 7
    s_add_u32 s57, s57, s58
    v_lshrrev_b32 v10, 3, v3
    v_and_b32 v11, 7, v0
    v_lshlrev_b32 v8, 16, v2
    v_lshl_add_u32 v8, v10, 18, v8
    v_lshl_add_u32 v8, v11, 4, v8
    s_waitcnt lgkmcnt(0)
    s_mov_b32 s32, s12
    s_mov_b32 s33, s13
    s_add_u32 s58, s57, 0
    buffer_load_dwordx4 v[64:67], v8, s[32:35], s58 offen nt
    s_add_u32 s58, s57, 8192
    buffer_load_dwordx4 v[68:71], v8, s[32:35], s58 offen nt
    s_add_u32 s58, s57, 16384
    buffer_load_dwordx4 v[72:75], v8, s[32:35], s58 offen nt
    s_add_u32 s58, s57, 24576
    buffer_load_dwordx4 v[76:79], v8, s[32:35], s58 offen nt
    s_add_u32 s58, s57, 32768
    buffer_load_dwordx4 v[80:83], v8, s[32:35], s58 offen nt
    s_add_u32 s58, s57, 40960
    buffer_load_dwordx4 v[84:87], v8, s[32:35], s58 offen nt
    s_add_u32 s58, s57, 49152
    buffer_load_dwordx4 v[88:91], v8, s[32:35], s58 offen nt
    s_add_u32 s58, s57, 57344
    buffer_load_dwordx4 v[92:95], v8, s[32:35], s58 offen nt
    s_and_b32 s29, s2, 15
    s_lshr_b32 s30, s2, 4
    s_lshr_b32 s53, s29, 2
    s_and_b32 s54, s29, 3
    s_mov_b32 s48, 0x05040100
    s_mov_b32 s49, 0x07060302
    s_mov_b32 s52, 4194304
    v_mov_b32 v1, 156928
    v_mov_b32 v4, 1
    v_lshlrev_b32 v5, 4, v0
    s_lshl_b32 s55, s31, 2
    v_add_u32 v6, s55, v1
    s_mov_b32 s42, 3145728
    s_mov_b32 s43, 0x20000
    s_mov_b32 s36, s14
    s_mov_b32 s37, s15
    s_mov_b32 s38, 0x400000
    s_mov_b32 s39, 0x20000
    s_mov_b32 s46, 8192
    s_mov_b32 s47, 0x20000
    v_lshlrev_b32 v9, 10, v11
    v_lshl_add_u32 v9, v2, 4, v9
    v_lshl_add_u32 v9, v10, 6, v9
    s_lshl_b32 s58, s56, 1
    buffer_load_dwordx4 v[16:19], v9, s[44:47], s58 offen
    s_lshl_b32 s58, s4, 7
    v_mov_b32 v10, 0
    buffer_load_dwordx2 v[20:21], v10, s[40:43], s58 offen sc1
    v_mov_b32 v24, -1
    v_mov_b32 v25, -1
    v_mov_b32 v26, -1
    v_mov_b32 v27, -1
    s_cmp_lg_u32 s31, 0
    s_cbranch_scc1 Lz_5
    v_lshl_add_u32 v13, v0, 2, v1
    ds_write_b32 v13, v10
    s_waitcnt lgkmcnt(0)
Lz_5:
    s_and_b32 s58, s31, 1
    s_lshl_b32 s59, s4, 1
    s_add_u32 s59, s59, s58
    s_lshl_b32 s60, s59, 18
    s_lshl_b32 s59, s54, 16
    s_add_u32 s60, s60, s59
    s_lshl_b32 s59, s26, 2
    s_add_u32 s59, s59, s53
    s_lshl_b32 s59, s59, 7
    s_add_u32 s60, s60, s59
    s_lshr_b32 s59, s31, 1
    s_lshl_b32 s59, s59, 6
    s_add_u32 s60, s60, s59
    s_add_u32 s60, s60, 2097152
    v_lshlrev_b32 v12, 12, v3
    v_lshl_add_u32 v12, v2, 4, v12
    buffer_store_dwordx4 v[24:27], v12, s[40:43], s60 offen sc1
    s_lshl_b32 s58, s2, 10
    s_lshl_b32 s59, s31, 8
    s_add_u32 s58, s58, s59
    s_add_u32 s58, s58, 65536
    s_mov_b64 exec, 0xffff
    buffer_store_dwordx4 v[24:27], v5, s[40:43], s58 offen sc1
    s_mov_b64 exec, -1
    s_lshl_b32 s58, s26, 19
    s_lshl_b32 s59, s31, 17
    s_add_u32 s58, s58, s59
    buffer_load_dword v240, v10, s[36:39], s58 offen
    s_mov_b32 s80, s20
    s_mov_b32 s81, s21
    s_mov_b32 s82, 16384
    s_mov_b32 s83, 0x20000
    buffer_load_dword v241, v10, s[80:83], 0 offen
    s_barrier
    s_waitcnt vmcnt(4)
    v_perm_b32 v96, v68, v64, s48
    v_perm_b32 v100, v68, v64, s49
    v_perm_b32 v104, v69, v65, s48
    v_perm_b32 v108, v69, v65, s49
    v_perm_b32 v112, v70, v66, s48
    v_perm_b32 v116, v70, v66, s49
    v_perm_b32 v120, v71, v67, s48
    v_perm_b32 v124, v71, v67, s49
    v_perm_b32 v97, v76, v72, s48
    v_perm_b32 v101, v76, v72, s49
    v_perm_b32 v105, v77, v73, s48
    v_perm_b32 v109, v77, v73, s49
    v_perm_b32 v113, v78, v74, s48
    v_perm_b32 v117, v78, v74, s49
    v_perm_b32 v121, v79, v75, s48
    v_perm_b32 v125, v79, v75, s49
    v_perm_b32 v98, v84, v80, s48
    v_perm_b32 v102, v84, v80, s49
    v_perm_b32 v106, v85, v81, s48
    v_perm_b32 v110, v85, v81, s49
    v_perm_b32 v114, v86, v82, s48
    v_perm_b32 v118, v86, v82, s49
    v_perm_b32 v122, v87, v83, s48
    v_perm_b32 v126, v87, v83, s49
    v_perm_b32 v99, v92, v88, s48
    v_perm_b32 v103, v92, v88, s49
    v_perm_b32 v107, v93, v89, s48
    v_perm_b32 v111, v93, v89, s49
    v_perm_b32 v115, v94, v90, s48
    v_perm_b32 v119, v94, v90, s49
    v_perm_b32 v123, v95, v91, s48
    v_perm_b32 v127, v95, v91, s49
    v_readfirstlane_b32 s50, v20
    v_readfirstlane_b32 s51, v21
    v_mfma_f32_16x16x32_bf16 v[128:131], v[16:19], v[96:99], 0
    v_mfma_f32_16x16x32_bf16 v[132:135], v[16:19], v[100:103], 0
    v_mfma_f32_16x16x32_bf16 v[136:139], v[16:19], v[104:107], 0
    v_mfma_f32_16x16x32_bf16 v[140:143], v[16:19], v[108:111], 0
    v_mfma_f32_16x16x32_bf16 v[144:147], v[16:19], v[112:115], 0
    v_mfma_f32_16x16x32_bf16 v[148:151], v[16:19], v[116:119], 0
    v_mfma_f32_16x16x32_bf16 v[152:155], v[16:19], v[120:123], 0
    v_mfma_f32_16x16x32_bf16 v[156:159], v[16:19], v[124:127], 0
    s_add_u32 s50, s50, 1
    s_addc_u32 s51, s51, 0
    s_lshl_b32 s55, s31, 12
    s_add_u32 s55, s55, 131072
    v_lshlrev_b32 v7, 7, v2
    v_lshl_add_u32 v7, v11, 4, v7
    v_add_u32 v7, s55, v7
    s_mov_b32 exec_lo, 0x00ff00ff
    s_mov_b32 exec_hi, 0xff00ff00
    s_nop 1
    ds_write_b128 v7, v[128:131] offset:0
    ds_write_b128 v7, v[132:135] offset:512
    ds_write_b128 v7, v[136:139] offset:1024
    ds_write_b128 v7, v[140:143] offset:1536
    ds_write_b128 v7, v[144:147] offset:2048
    ds_write_b128 v7, v[148:151] offset:2560
    ds_write_b128 v7, v[152:155] offset:3072
    ds_write_b128 v7, v[156:159] offset:3584
    s_mov_b64 exec, -1
    s_waitcnt lgkmcnt(0)
    ds_write_b32 v6, v4 offset:0
    s_lshl_b32 s55, s31, 10
    s_add_u32 s55, s55, 131072
    v_lshlrev_b32 v7, 2, v0
    v_add_u32 v7, s55, v7
    v_and_b32 v8, 3, v0
    v_lshlrev_b32 v8, 13, v8
    v_lshrrev_b32 v9, 5, v0
    v_lshl_add_u32 v8, v9, 15, v8
    v_bfe_u32 v9, v0, 2, 3
    v_lshl_add_u32 v8, v9, 4, v8
    s_lshl_b32 s59, s30, 16
    s_lshl_b32 s61, s28, 12
    s_add_u32 s59, s59, s61
    s_lshl_b32 s61, s27, 9
    s_add_u32 s59, s59, s61
    s_lshl_b32 s61, s31, 7
    s_add_u32 s59, s59, s61
    s_add_u32 s59, s59, 1048576
    v_mov_b32 v66, s50
    v_mov_b32 v67, s51
Lw_6:
    ds_read_b128 v[244:247], v1 offset:0
    s_waitcnt lgkmcnt(0)
    v_and_b32 v244, v244, v245
    v_and_b32 v246, v246, v247
    v_and_b32 v244, v244, v246
    s_nop 0
    v_readfirstlane_b32 s55, v244
    s_cmp_eq_u32 s55, 1
    s_cbranch_scc1 Ld_7
    s_sub_u32 s52, s52, 1
    s_cbranch_scc1 L_end
    s_sleep 1
    s_branch Lw_6
Ld_7:
    ds_read2st64_b32 v[68:69], v7 offset0:0 offset1:2
    ds_read2st64_b32 v[70:71], v7 offset0:1 offset1:3
    ds_read2st64_b32 v[72:73], v7 offset0:16 offset1:18
    ds_read2st64_b32 v[74:75], v7 offset0:17 offset1:19
    ds_read2st64_b32 v[76:77], v7 offset0:32 offset1:34
    ds_read2st64_b32 v[78:79], v7 offset0:33 offset1:35
    ds_read2st64_b32 v[80:81], v7 offset0:48 offset1:50
    ds_read2st64_b32 v[82:83], v7 offset0:49 offset1:51
    s_waitcnt lgkmcnt(0)
    v_add_f32 v68, v68, v70
    v_add_f32 v69, v69, v71
    v_add_f32 v72, v72, v74
    v_add_f32 v73, v73, v75
    v_add_f32 v76, v76, v78
    v_add_f32 v77, v77, v79
    v_add_f32 v80, v80, v82
    v_add_f32 v81, v81, v83
    v_add_f32 v68, v68, v72
    v_add_f32 v69, v69, v73
    v_add_f32 v76, v76, v80
    v_add_f32 v77, v77, v81
    v_add_f32 v64, v68, v76
    v_add_f32 v65, v69, v77
    buffer_store_dwordx4 v[64:67], v8, s[40:43], s59 offen sc1
    s_lshl_b32 s58, s30, 16
    s_lshl_b32 s59, s27, 13
    s_add_u32 s58, s58, s59
    s_lshl_b32 s59, s31, 10
    s_add_u32 s58, s58, s59
    s_add_u32 s58, s58, 1048576
    s_add_u32 s59, s58, 4096
    v_lshrrev_b32 v8, 5, v0
    v_lshlrev_b32 v8, 7, v8
    v_lshl_add_u32 v8, v11, 4, v8
    v_bfe_u32 v9, v0, 3, 2
    v_lshl_add_u32 v8, v9, 2, v8
    s_lshl_b32 s55, s31, 8
    s_add_u32 s55, s55, 155648
    v_add_u32 v8, s55, v8
Lp_8:
    s_sleep 24
    buffer_load_dwordx4 v[68:71], v5, s[40:43], s58 offen sc1
    buffer_load_dwordx4 v[72:75], v5, s[40:43], s59 offen sc1
    s_waitcnt vmcnt(0)
    v_cmp_ne_u64 vcc, v[70:71], v[66:67]
    v_cmp_ne_u64 s[56:57], v[74:75], v[66:67]
    s_or_b64 exec, vcc, s[56:57]
    s_cbranch_execz Ld_9
    s_sub_u32 s52, s52, 1
    s_cbranch_scc1 L_end
    s_branch Lp_8
Ld_9:
    s_mov_b64 exec, -1
    v_add_f32 v68, v68, v72
    v_add_f32 v69, v69, v73
    v_cvt_pk_bf16_f32 v68, v68, v69
    ds_write_b32 v8, v68
    ds_write_b32 v6, v4 offset:16
    s_waitcnt lgkmcnt(0)
    ds_write_b32 v6, v4 offset:32
    s_cmp_lg_u32 s31, 0
    s_cbranch_scc1 Lgo_10
Lw_11:
    ds_read_b128 v[244:247], v1 offset:16
    s_waitcnt lgkmcnt(0)
    v_and_b32 v244, v244, v245
    v_and_b32 v246, v246, v247
    v_and_b32 v244, v244, v246
    s_nop 0
    v_readfirstlane_b32 s55, v244
    s_cmp_eq_u32 s55, 1
    s_cbranch_scc1 Ld_12
    s_sub_u32 s52, s52, 1
    s_cbranch_scc1 L_end
    s_sleep 1
    s_branch Lw_11
Ld_12:
    s_lshl_b32 s58, s30, 7
    s_add_u32 s58, s58, 4096
    s_lshl_b32 s59, s29, 3
    v_mov_b32 v22, s59
    s_mov_b64 exec, 1
    buffer_store_dwordx2 v[66:67], v22, s[40:43], s58 offen sc1
    s_mov_b64 exec, -1
Lgo_10:
    v_and_b32 v8, 3, v3
    v_lshlrev_b32 v8, 2, v8
    v_lshrrev_b32 v9, 2, v3
    v_add_u32 v8, v8, v9
    v_lshlrev_b32 v8, 8, v8
    s_lshl_b32 s55, s31, 15
    v_add_u32 v8, s55, v8
    v_add_u32 v9, 0, v2
    v_xor_b32 v9, v9, v3
    v_lshl_add_u32 v28, v9, 4, v8
    v_add_u32 v9, 4, v2
    v_xor_b32 v9, v9, v3
    v_lshl_add_u32 v29, v9, 4, v8
    v_add_u32 v9, 8, v2
    v_xor_b32 v9, v9, v3
    v_lshl_add_u32 v30, v9, 4, v8
    v_add_u32 v9, 12, v2
    v_xor_b32 v9, v9, v3
    v_lshl_add_u32 v31, v9, 4, v8
    v_and_b32 v9, 3, v3
    v_lshlrev_b32 v9, 8, v9
    v_lshl_add_u32 v9, v2, 4, v9
    v_add_u32 v9, 155648, v9
Lw_13:
    ds_read_b128 v[244:247], v1 offset:32
    s_waitcnt lgkmcnt(0)
    v_and_b32 v244, v244, v245
    v_and_b32 v246, v246, v247
    v_and_b32 v244, v244, v246
    s_nop 0
    v_readfirstlane_b32 s55, v244
    s_cmp_eq_u32 s55, 1
    s_cbranch_scc1 Ld_14
    s_sub_u32 s52, s52, 1
    s_cbranch_scc1 L_end
    s_sleep 1
    s_branch Lw_13
Ld_14:
    ds_read_b128 v[32:35], v9 offset:0
    ds_read_b128 v[36:39], v9 offset:64
    ds_read_b128 v[40:43], v9 offset:128
    ds_read_b128 v[44:47], v9 offset:192
Lw_15:
    ds_read_b32 v244, v6 offset:48
    s_waitcnt lgkmcnt(0)
    v_readfirstlane_b32 s55, v244
    s_cmp_eq_u32 s55, 1
    s_cbranch_scc1 Ld_16
    s_sub_u32 s52, s52, 1
    s_cbranch_scc1 L_end
    s_sleep 1
    s_branch Lw_15
Ld_16:
    ds_read_b128 v[64:67], v28 offset:0
    ds_read_b128 v[68:71], v29 offset:0
    ds_read_b128 v[72:75], v30 offset:0
    ds_read_b128 v[76:79], v31 offset:0
    ds_read_b128 v[80:83], v28 offset:4096
    ds_read_b128 v[84:87], v29 offset:4096
    ds_read_b128 v[88:91], v30 offset:4096
    ds_read_b128 v[92:95], v31 offset:4096
    ds_read_b128 v[96:99], v28 offset:8192
    ds_read_b128 v[100:103], v29 offset:8192
    ds_read_b128 v[104:107], v30 offset:8192
    ds_read_b128 v[108:111], v31 offset:8192
    s_waitcnt lgkmcnt(8)
    v_mfma_f32_16x16x32_bf16 v[128:131], v[64:67], v[32:35], 0
    v_mfma_f32_16x16x32_bf16 v[128:131], v[68:71], v[36:39], v[128:131]
    v_mfma_f32_16x16x32_bf16 v[128:131], v[72:75], v[40:43], v[128:131]
    v_mfma_f32_16x16x32_bf16 v[128:131], v[76:79], v[44:47], v[128:131]
    ds_read_b128 v[112:115], v28 offset:12288
    ds_read_b128 v[116:119], v29 offset:12288
    ds_read_b128 v[120:123], v30 offset:12288
    ds_read_b128 v[124:127], v31 offset:12288
    s_waitcnt lgkmcnt(8)
    v_mfma_f32_16x16x32_bf16 v[132:135], v[80:83], v[32:35], 0
    v_mfma_f32_16x16x32_bf16 v[132:135], v[84:87], v[36:39], v[132:135]
    v_mfma_f32_16x16x32_bf16 v[132:135], v[88:91], v[40:43], v[132:135]
    v_mfma_f32_16x16x32_bf16 v[132:135], v[92:95], v[44:47], v[132:135]
    ds_read_b128 v[64:67], v28 offset:16384
    ds_read_b128 v[68:71], v29 offset:16384
    ds_read_b128 v[72:75], v30 offset:16384
    ds_read_b128 v[76:79], v31 offset:16384
    s_waitcnt lgkmcnt(8)
    v_mfma_f32_16x16x32_bf16 v[136:139], v[96:99], v[32:35], 0
    v_mfma_f32_16x16x32_bf16 v[136:139], v[100:103], v[36:39], v[136:139]
    v_mfma_f32_16x16x32_bf16 v[136:139], v[104:107], v[40:43], v[136:139]
    v_mfma_f32_16x16x32_bf16 v[136:139], v[108:111], v[44:47], v[136:139]
    ds_read_b128 v[80:83], v28 offset:20480
    ds_read_b128 v[84:87], v29 offset:20480
    ds_read_b128 v[88:91], v30 offset:20480
    ds_read_b128 v[92:95], v31 offset:20480
    s_waitcnt lgkmcnt(8)
    v_mfma_f32_16x16x32_bf16 v[140:143], v[112:115], v[32:35], 0
    v_mfma_f32_16x16x32_bf16 v[140:143], v[116:119], v[36:39], v[140:143]
    v_mfma_f32_16x16x32_bf16 v[140:143], v[120:123], v[40:43], v[140:143]
    v_mfma_f32_16x16x32_bf16 v[140:143], v[124:127], v[44:47], v[140:143]
    ds_read_b128 v[96:99], v28 offset:24576
    ds_read_b128 v[100:103], v29 offset:24576
    ds_read_b128 v[104:107], v30 offset:24576
    ds_read_b128 v[108:111], v31 offset:24576
    s_waitcnt lgkmcnt(8)
    v_mfma_f32_16x16x32_bf16 v[144:147], v[64:67], v[32:35], 0
    v_mfma_f32_16x16x32_bf16 v[144:147], v[68:71], v[36:39], v[144:147]
    v_mfma_f32_16x16x32_bf16 v[144:147], v[72:75], v[40:43], v[144:147]
    v_mfma_f32_16x16x32_bf16 v[144:147], v[76:79], v[44:47], v[144:147]
    ds_read_b128 v[112:115], v28 offset:28672
    ds_read_b128 v[116:119], v29 offset:28672
    ds_read_b128 v[120:123], v30 offset:28672
    ds_read_b128 v[124:127], v31 offset:28672
    s_waitcnt lgkmcnt(8)
    v_mfma_f32_16x16x32_bf16 v[148:151], v[80:83], v[32:35], 0
    v_mfma_f32_16x16x32_bf16 v[148:151], v[84:87], v[36:39], v[148:151]
    v_mfma_f32_16x16x32_bf16 v[148:151], v[88:91], v[40:43], v[148:151]
    v_mfma_f32_16x16x32_bf16 v[148:151], v[92:95], v[44:47], v[148:151]
    s_waitcnt lgkmcnt(4)
    v_mfma_f32_16x16x32_bf16 v[152:155], v[96:99], v[32:35], 0
    v_mfma_f32_16x16x32_bf16 v[152:155], v[100:103], v[36:39], v[152:155]
    v_mfma_f32_16x16x32_bf16 v[152:155], v[104:107], v[40:43], v[152:155]
    v_mfma_f32_16x16x32_bf16 v[152:155], v[108:111], v[44:47], v[152:155]
    s_waitcnt lgkmcnt(0)
    v_mfma_f32_16x16x32_bf16 v[156:159], v[112:115], v[32:35], 0
    v_mfma_f32_16x16x32_bf16 v[156:159], v[116:119], v[36:39], v[156:159]
    v_mfma_f32_16x16x32_bf16 v[156:159], v[120:123], v[40:43], v[156:159]
    v_mfma_f32_16x16x32_bf16 v[156:159], v[124:127], v[44:47], v[156:159]
    s_mov_b32 s58, 0x3fb8aa3b
    s_mov_b32 s59, 0x3db504f3
    s_mov_b32 s57, 0xffff0000
    s_nop 6
    v_cvt_pk_bf16_f32 v64, v128, v129
    v_cvt_pk_bf16_f32 v65, v130, v131
    v_cvt_pk_bf16_f32 v66, v132, v133
    v_cvt_pk_bf16_f32 v67, v134, v135
    v_cvt_pk_bf16_f32 v68, v136, v137
    v_cvt_pk_bf16_f32 v69, v138, v139
    v_cvt_pk_bf16_f32 v70, v140, v141
    v_cvt_pk_bf16_f32 v71, v142, v143
    v_cvt_pk_bf16_f32 v72, v144, v145
    v_cvt_pk_bf16_f32 v73, v146, v147
    v_cvt_pk_bf16_f32 v74, v148, v149
    v_cvt_pk_bf16_f32 v75, v150, v151
    v_cvt_pk_bf16_f32 v76, v152, v153
    v_cvt_pk_bf16_f32 v77, v154, v155
    v_cvt_pk_bf16_f32 v78, v156, v157
    v_cvt_pk_bf16_f32 v79, v158, v159
    v_lshlrev_b32 v128, 16, v64
    v_and_b32 v129, s57, v64
    v_lshlrev_b32 v130, 16, v65
    v_and_b32 v131, s57, v65
    v_lshlrev_b32 v132, 16, v66
    v_and_b32 v133, s57, v66
    v_lshlrev_b32 v134, 16, v67
    v_and_b32 v135, s57, v67
    v_lshlrev_b32 v136, 16, v68
    v_and_b32 v137, s57, v68
    v_lshlrev_b32 v138, 16, v69
    v_and_b32 v139, s57, v69
    v_lshlrev_b32 v140, 16, v70
    v_and_b32 v141, s57, v70
    v_lshlrev_b32 v142, 16, v71
    v_and_b32 v143, s57, v71
    v_lshlrev_b32 v144, 16, v72
    v_and_b32 v145, s57, v72
    v_lshlrev_b32 v146, 16, v73
    v_and_b32 v147, s57, v73
    v_lshlrev_b32 v148, 16, v74
    v_and_b32 v149, s57, v74
    v_lshlrev_b32 v150, 16, v75
    v_and_b32 v151, s57, v75
    v_lshlrev_b32 v152, 16, v76
    v_and_b32 v153, s57, v76
    v_lshlrev_b32 v154, 16, v77
    v_and_b32 v155, s57, v77
    v_lshlrev_b32 v156, 16, v78
    v_and_b32 v157, s57, v78
    v_lshlrev_b32 v158, 16, v79
    v_and_b32 v159, s57, v79
    v_mul_f32 v128, s59, v128
    v_mul_f32 v129, s59, v129
    v_mul_f32 v130, s59, v130
    v_mul_f32 v131, s59, v131
    v_mul_f32 v132, s59, v132
    v_mul_f32 v133, s59, v133
    v_mul_f32 v134, s59, v134
    v_mul_f32 v135, s59, v135
    v_mul_f32 v136, s59, v136
    v_mul_f32 v137, s59, v137
    v_mul_f32 v138, s59, v138
    v_mul_f32 v139, s59, v139
    v_mul_f32 v140, s59, v140
    v_mul_f32 v141, s59, v141
    v_mul_f32 v142, s59, v142
    v_mul_f32 v143, s59, v143
    v_mul_f32 v144, s59, v144
    v_mul_f32 v145, s59, v145
    v_mul_f32 v146, s59, v146
    v_mul_f32 v147, s59, v147
    v_mul_f32 v148, s59, v148
    v_mul_f32 v149, s59, v149
    v_mul_f32 v150, s59, v150
    v_mul_f32 v151, s59, v151
    v_mul_f32 v152, s59, v152
    v_mul_f32 v153, s59, v153
    v_mul_f32 v154, s59, v154
    v_mul_f32 v155, s59, v155
    v_mul_f32 v156, s59, v156
    v_mul_f32 v157, s59, v157
    v_mul_f32 v158, s59, v158
    v_mul_f32 v159, s59, v159
    v_cvt_pk_bf16_f32 v64, v128, v129
    v_cvt_pk_bf16_f32 v65, v130, v131
    v_cvt_pk_bf16_f32 v66, v132, v133
    v_cvt_pk_bf16_f32 v67, v134, v135
    v_cvt_pk_bf16_f32 v68, v136, v137
    v_cvt_pk_bf16_f32 v69, v138, v139
    v_cvt_pk_bf16_f32 v70, v140, v141
    v_cvt_pk_bf16_f32 v71, v142, v143
    v_cvt_pk_bf16_f32 v72, v144, v145
    v_cvt_pk_bf16_f32 v73, v146, v147
    v_cvt_pk_bf16_f32 v74, v148, v149
    v_cvt_pk_bf16_f32 v75, v150, v151
    v_cvt_pk_bf16_f32 v76, v152, v153
    v_cvt_pk_bf16_f32 v77, v154, v155
    v_cvt_pk_bf16_f32 v78, v156, v157
    v_cvt_pk_bf16_f32 v79, v158, v159
    v_lshlrev_b32 v128, 16, v64
    v_and_b32 v129, s57, v64
    v_lshlrev_b32 v130, 16, v65
    v_and_b32 v131, s57, v65
    v_lshlrev_b32 v132, 16, v66
    v_and_b32 v133, s57, v66
    v_lshlrev_b32 v134, 16, v67
    v_and_b32 v135, s57, v67
    v_lshlrev_b32 v136, 16, v68
    v_and_b32 v137, s57, v68
    v_lshlrev_b32 v138, 16, v69
    v_and_b32 v139, s57, v69
    v_lshlrev_b32 v140, 16, v70
    v_and_b32 v141, s57, v70
    v_lshlrev_b32 v142, 16, v71
    v_and_b32 v143, s57, v71
    v_lshlrev_b32 v144, 16, v72
    v_and_b32 v145, s57, v72
    v_lshlrev_b32 v146, 16, v73
    v_and_b32 v147, s57, v73
    v_lshlrev_b32 v148, 16, v74
    v_and_b32 v149, s57, v74
    v_lshlrev_b32 v150, 16, v75
    v_and_b32 v151, s57, v75
    v_lshlrev_b32 v152, 16, v76
    v_and_b32 v153, s57, v76
    v_lshlrev_b32 v154, 16, v77
    v_and_b32 v155, s57, v77
    v_lshlrev_b32 v156, 16, v78
    v_and_b32 v157, s57, v78
    v_lshlrev_b32 v158, 16, v79
    v_and_b32 v159, s57, v79
    v_max3_f32 v10, v128, v129, v130
    v_max3_f32 v11, v131, v132, v133
    v_max3_f32 v10, v10, v134, v135
    v_max3_f32 v11, v11, v136, v137
    v_max3_f32 v10, v10, v138, v139
    v_max3_f32 v11, v11, v140, v141
    v_max3_f32 v10, v10, v142, v143
    v_max3_f32 v11, v11, v144, v145
    v_max3_f32 v10, v10, v146, v147
    v_max3_f32 v11, v11, v148, v149
    v_max3_f32 v10, v10, v150, v151
    v_max3_f32 v11, v11, v152, v153
    v_max3_f32 v10, v10, v154, v155
    v_max3_f32 v11, v11, v156, v157
    v_max3_f32 v10, v10, v158, v159
    v_max_f32 v10, v10, v11
    v_mov_b32 v11, v10
    s_nop 1
    v_permlane32_swap_b32 v10, v11
    s_nop 1
    v_max_f32 v10, v10, v11
    v_mov_b32 v11, v10
    s_nop 1
    v_permlane16_swap_b32 v10, v11
    s_nop 1
    v_max_f32 v10, v10, v11
    v_mul_f32 v10, s58, v10
    v_sub_f32 v13, 0, v10
    v_fma_f32 v128, v128, s58, v13
    v_fma_f32 v129, v129, s58, v13
    v_fma_f32 v130, v130, s58, v13
    v_fma_f32 v131, v131, s58, v13
    v_fma_f32 v132, v132, s58, v13
    v_fma_f32 v133, v133, s58, v13
    v_fma_f32 v134, v134, s58, v13
    v_fma_f32 v135, v135, s58, v13
    v_fma_f32 v136, v136, s58, v13
    v_fma_f32 v137, v137, s58, v13
    v_fma_f32 v138, v138, s58, v13
    v_fma_f32 v139, v139, s58, v13
    v_fma_f32 v140, v140, s58, v13
    v_fma_f32 v141, v141, s58, v13
    v_fma_f32 v142, v142, s58, v13
    v_fma_f32 v143, v143, s58, v13
    v_fma_f32 v144, v144, s58, v13
    v_fma_f32 v145, v145, s58, v13
    v_fma_f32 v146, v146, s58, v13
    v_fma_f32 v147, v147, s58, v13
    v_fma_f32 v148, v148, s58, v13
    v_fma_f32 v149, v149, s58, v13
    v_fma_f32 v150, v150, s58, v13
    v_fma_f32 v151, v151, s58, v13
    v_fma_f32 v152, v152, s58, v13
    v_fma_f32 v153, v153, s58, v13
    v_fma_f32 v154, v154, s58, v13
    v_fma_f32 v155, v155, s58, v13
    v_fma_f32 v156, v156, s58, v13
    v_fma_f32 v157, v157, s58, v13
    v_fma_f32 v158, v158, s58, v13
    v_fma_f32 v159, v159, s58, v13
    v_exp_f32 v128, v128
    v_exp_f32 v129, v129
    v_exp_f32 v130, v130
    v_exp_f32 v131, v131
    v_exp_f32 v132, v132
    v_exp_f32 v133, v133
    v_exp_f32 v134, v134
    v_exp_f32 v135, v135
    v_exp_f32 v136, v136
    v_exp_f32 v137, v137
    v_exp_f32 v138, v138
    v_exp_f32 v139, v139
    v_exp_f32 v140, v140
    v_exp_f32 v141, v141
    v_exp_f32 v142, v142
    v_exp_f32 v143, v143
    v_exp_f32 v144, v144
    v_exp_f32 v145, v145
    v_exp_f32 v146, v146
    v_exp_f32 v147, v147
    v_exp_f32 v148, v148
    v_exp_f32 v149, v149
    v_exp_f32 v150, v150
    v_exp_f32 v151, v151
    v_exp_f32 v152, v152
    v_exp_f32 v153, v153
    v_exp_f32 v154, v154
    v_exp_f32 v155, v155
    v_exp_f32 v156, v156
    v_exp_f32 v157, v157
    v_exp_f32 v158, v158
    v_exp_f32 v159, v159
    s_nop 0
    v_add_f32 v11, v128, v129
    v_add_f32 v14, v130, v131
    v_add_f32 v11, v11, v132
    v_add_f32 v14, v14, v133
    v_add_f32 v11, v11, v134
    v_add_f32 v14, v14, v135
    v_add_f32 v11, v11, v136
    v_add_f32 v14, v14, v137
    v_add_f32 v11, v11, v138
    v_add_f32 v14, v14, v139
    v_add_f32 v11, v11, v140
    v_add_f32 v14, v14, v141
    v_add_f32 v11, v11, v142
    v_add_f32 v14, v14, v143
    v_add_f32 v11, v11, v144
    v_add_f32 v14, v14, v145
    v_add_f32 v11, v11, v146
    v_add_f32 v14, v14, v147
    v_add_f32 v11, v11, v148
    v_add_f32 v14, v14, v149
    v_add_f32 v11, v11, v150
    v_add_f32 v14, v14, v151
    v_add_f32 v11, v11, v152
    v_add_f32 v14, v14, v153
    v_add_f32 v11, v11, v154
    v_add_f32 v14, v14, v155
    v_add_f32 v11, v11, v156
    v_add_f32 v14, v14, v157
    v_add_f32 v11, v11, v158
    v_add_f32 v14, v14, v159
    v_add_f32 v11, v11, v14
    v_cvt_pk_bf16_f32 v64, v128, v129
    v_cvt_pk_bf16_f32 v65, v130, v131
    v_cvt_pk_bf16_f32 v66, v132, v133
    v_cvt_pk_bf16_f32 v67, v134, v135
    v_cvt_pk_bf16_f32 v68, v136, v137
    v_cvt_pk_bf16_f32 v69, v138, v139
    v_cvt_pk_bf16_f32 v70, v140, v141
    v_cvt_pk_bf16_f32 v71, v142, v143
    v_cvt_pk_bf16_f32 v72, v144, v145
    v_cvt_pk_bf16_f32 v73, v146, v147
    v_cvt_pk_bf16_f32 v74, v148, v149
    v_cvt_pk_bf16_f32 v75, v150, v151
    v_cvt_pk_bf16_f32 v76, v152, v153
    v_cvt_pk_bf16_f32 v77, v154, v155
    v_cvt_pk_bf16_f32 v78, v156, v157
    v_cvt_pk_bf16_f32 v79, v158, v159
    s_lshl_b32 s55, s31, 12
    v_add_u32 v7, s55, v5
    v_add_u32 v7, 131072, v7
    ds_write_b128 v7, v[64:67] offset:0
    ds_write_b128 v7, v[68:71] offset:1024
    ds_write_b128 v7, v[72:75] offset:2048
    ds_write_b128 v7, v[76:79] offset:3072
    v_mov_b32 v14, v11
    s_nop 1
    v_permlane32_swap_b32 v11, v14
    s_nop 1
    v_add_f32 v11, v11, v14
    v_mov_b32 v14, v11
    s_nop 1
    v_permlane16_swap_b32 v11, v14
    s_nop 1
    v_add_f32 v11, v11, v14
    s_lshl_b32 s55, s31, 5
    s_add_u32 s55, s55, 156672
    v_lshlrev_b32 v8, 3, v0
    v_add_u32 v8, s55, v8
    s_mov_b64 exec, 0xf
    ds_write_b64 v8, v[10:11]
    s_mov_b64 exec, -1
    s_waitcnt lgkmcnt(0)
    ds_write_b32 v6, v4 offset:80
    ds_write_b32 v6, v4 offset:96
    s_cmp_eq_u32 s31, 0
    s_cbranch_scc1 Ls_18
    s_cmp_lg_u32 s31, 3
    s_cbranch_scc1 Ls_19
Lw_20:
    ds_read_b128 v[244:247], v1 offset:96
    s_waitcnt lgkmcnt(0)
    v_and_b32 v244, v244, v245
    v_and_b32 v246, v246, v247
    v_and_b32 v244, v244, v246
    s_nop 0
    v_readfirstlane_b32 s55, v244
    s_cmp_eq_u32 s55, 1
    s_cbranch_scc1 Ld_21
    s_sub_u32 s52, s52, 1
    s_cbranch_scc1 L_end
    s_sleep 1
    s_branch Lw_20
Ld_21:
    s_mov_b64 exec, 0xffff
    v_lshlrev_b32 v8, 3, v0
    v_add_u32 v8, 156672, v8
    ds_read_b64 v[10:11], v8
    s_waitcnt lgkmcnt(0)
    v_max_f32_dpp v13, v10, v10 row_ror:4 row_mask:0xf bank_mask:0xf
    s_nop 1
    v_max_f32_dpp v13, v13, v13 row_ror:8 row_mask:0xf bank_mask:0xf
    v_sub_f32 v14, v10, v13
    v_exp_f32 v14, v14
    s_nop 0
    v_mul_f32 v14, v14, v11
    s_nop 1
    v_add_f32_dpp v15, v14, v14 row_ror:4 row_mask:0xf bank_mask:0xf
    s_nop 1
    v_add_f32_dpp v15, v15, v15 row_ror:8 row_mask:0xf bank_mask:0xf
    v_mov_b32 v20, v13
    v_mov_b32 v21, v15
    v_mov_b32 v22, s50
    v_mov_b32 v23, s51
    v_and_b32 v9, 3, v0
    v_lshlrev_b32 v9, 4, v9
    s_lshl_b32 s58, s2, 7
    s_add_u32 s58, s58, 8192
    s_xor_b32 s59, s58, 128
    s_mov_b64 exec, 0xf
    buffer_store_dwordx4 v[20:23], v9, s[40:43], s58 offen sc1
    s_mov_b64 exec, 0xffff
Lp_22:
    buffer_load_dwordx4 v[24:27], v9, s[40:43], s59 offen sc1
    s_waitcnt vmcnt(0)
    v_cmp_ne_u64 vcc, v[26:27], v[22:23]
    s_cbranch_vccz Ld_23
    s_sub_u32 s52, s52, 1
    s_cbranch_scc1 L_end
    s_sleep 2
    s_branch Lp_22
Ld_23:
    v_max_f32 v26, v13, v24
    v_sub_f32 v27, v13, v26
    v_sub_f32 v20, v24, v26
    v_sub_f32 v21, v10, v26
    v_exp_f32 v27, v27
    v_exp_f32 v20, v20
    v_exp_f32 v21, v21
    s_nop 0
    v_mul_f32 v27, v27, v15
    v_fmac_f32 v27, v20, v25
    v_rcp_f32 v27, v27
    s_nop 0
    v_mul_f32 v21, v21, v27
    v_lshlrev_b32 v8, 2, v0
    v_add_u32 v8, 156800, v8
    ds_write_b32 v8, v21
    s_mov_b64 exec, -1
    s_waitcnt lgkmcnt(0)
    s_branch Ls_19
Ls_18:
    s_lshl_b32 s58, s4, 10
    s_add_u32 s58, s58, 4096
    v_mov_b32 v20, s50
    v_mov_b32 v21, s51
Lp_24:
    buffer_load_dwordx4 v[24:27], v5, s[40:43], s58 offen sc1
    s_waitcnt vmcnt(0)
    v_cmp_ne_u64 vcc, v[24:25], v[20:21]
    v_cmp_ne_u64 s[56:57], v[26:27], v[20:21]
    s_or_b64 vcc, vcc, s[56:57]
    s_cbranch_vccz Ld_25
    s_sub_u32 s52, s52, 1
    s_cbranch_scc1 L_end
    s_sleep 2
    s_branch Lp_24
Ld_25:
Ls_19:
Lw_26:
    ds_read_b32 v244, v6 offset:64
    s_waitcnt lgkmcnt(0)
    v_readfirstlane_b32 s55, v244
    s_cmp_eq_u32 s55, 1
    s_cbranch_scc1 Ld_27
    s_sub_u32 s52, s52, 1
    s_cbranch_scc1 L_end
    s_sleep 1
    s_branch Lw_26
Ld_27:
    s_lshl_b32 s56, s26, 9
    s_and_b32 s57, s31, 1
    s_lshl_b32 s57, s57, 6
    s_add_u32 s56, s56, s57
    s_lshl_b32 s57, s53, 1
    s_add_u32 s56, s56, s57
    s_lshr_b32 s57, s31, 1
    s_add_u32 s56, s56, s57
    s_lshl_b32 s56, s56, 10
    s_lshl_b32 s57, s54, 8
    s_add_u32 s56, s56, s57
    v_lshlrev_b32 v8, 14, v2
    v_lshl_add_u32 v8, v3, 4, v8
    s_add_u32 s57, s56, 0
    buffer_load_dwordx4 v[64:67], v8, s[36:39], s57 offen nt
    s_add_u32 s57, s56, 131072
    buffer_load_dwordx4 v[68:71], v8, s[36:39], s57 offen nt
    s_add_u32 s57, s56, 262144
    buffer_load_dwordx4 v[72:75], v8, s[36:39], s57 offen nt
    s_add_u32 s57, s56, 393216
    buffer_load_dwordx4 v[76:79], v8, s[36:39], s57 offen nt
    s_add_u32 s57, s56, 8192
    buffer_load_dwordx4 v[80:83], v8, s[36:39], s57 offen nt
    s_add_u32 s57, s56, 139264
    buffer_load_dwordx4 v[84:87], v8, s[36:39], s57 offen nt
    s_add_u32 s57, s56, 270336
    buffer_load_dwordx4 v[88:91], v8, s[36:39], s57 offen nt
    s_add_u32 s57, s56, 401408
    buffer_load_dwordx4 v[92:95], v8, s[36:39], s57 offen nt
    v_and_b32 v9, 7, v0
    v_lshlrev_b32 v9, 11, v9
    v_lshrrev_b32 v10, 3, v3
    v_lshl_add_u32 v9, v10, 10, v9
    v_lshl_add_u32 v9, v2, 4, v9
    s_lshl_b32 s58, s30, 14
    s_lshl_b32 s59, s53, 8
    s_add_u32 s58, s58, s59
    s_lshl_b32 s59, s31, 6
    s_add_u32 s58, s58, s59
    s_add_u32 s58, s58, 65536
    s_barrier
    s_waitcnt vmcnt(0)
    v_perm_b32 v96, v68, v64, s48
    v_perm_b32 v100, v68, v64, s49
    v_perm_b32 v104, v69, v65, s48
    v_perm_b32 v108, v69, v65, s49
    v_perm_b32 v112, v70, v66, s48
    v_perm_b32 v116, v70, v66, s49
    v_perm_b32 v120, v71, v67, s48
    v_perm_b32 v124, v71, v67, s49
    v_perm_b32 v97, v76, v72, s48
    v_perm_b32 v101, v76, v72, s49
    v_perm_b32 v105, v77, v73, s48
    v_perm_b32 v109, v77, v73, s49
    v_perm_b32 v113, v78, v74, s48
    v_perm_b32 v117, v78, v74, s49
    v_perm_b32 v121, v79, v75, s48
    v_perm_b32 v125, v79, v75, s49
    v_perm_b32 v98, v84, v80, s48
    v_perm_b32 v102, v84, v80, s49
    v_perm_b32 v106, v85, v81, s48
    v_perm_b32 v110, v85, v81, s49
    v_perm_b32 v114, v86, v82, s48
    v_perm_b32 v118, v86, v82, s49
    v_perm_b32 v122, v87, v83, s48
    v_perm_b32 v126, v87, v83, s49
    v_perm_b32 v99, v92, v88, s48
    v_perm_b32 v103, v92, v88, s49
    v_perm_b32 v107, v93, v89, s48
    v_perm_b32 v111, v93, v89, s49
    v_perm_b32 v115, v94, v90, s48
    v_perm_b32 v119, v94, v90, s49
    v_perm_b32 v123, v95, v91, s48
    v_perm_b32 v127, v95, v91, s49
Lp_28:
    buffer_load_dwordx4 v[16:19], v9, s[40:43], s58 offen sc1
    s_waitcnt vmcnt(0)
    v_max3_u32 v24, v16, v17, v18
    v_max_u32 v24, v24, v19
    v_cmp_eq_u32 vcc, -1, v24
    s_mov_b64 exec, vcc
    s_cbranch_execz Ld_29
    s_sub_u32 s52, s52, 1
    s_cbranch_scc1 L_end
    s_sleep 2
    s_branch Lp_28
Ld_29:
    s_mov_b64 exec, -1
    s_nop 3
    v_mfma_f32_16x16x32_bf16 v[128:131], v[16:19], v[96:99], 0
    v_mfma_f32_16x16x32_bf16 v[132:135], v[16:19], v[100:103], 0
    v_mfma_f32_16x16x32_bf16 v[136:139], v[16:19], v[104:107], 0
    v_mfma_f32_16x16x32_bf16 v[140:143], v[16:19], v[108:111], 0
    v_mfma_f32_16x16x32_bf16 v[144:147], v[16:19], v[112:115], 0
    v_mfma_f32_16x16x32_bf16 v[148:151], v[16:19], v[116:119], 0
    v_mfma_f32_16x16x32_bf16 v[152:155], v[16:19], v[120:123], 0
    v_mfma_f32_16x16x32_bf16 v[156:159], v[16:19], v[124:127], 0
    s_lshl_b32 s55, s31, 13
    v_add_u32 v7, s55, v5
    s_lshr_b32 s55, s31, 1
    s_lshl_b32 s55, s55, 12
    s_and_b32 s56, s31, 1
    s_lshl_b32 s56, s56, 8
    s_add_u32 s55, s55, s56
    v_lshlrev_b32 v8, 10, v2
    v_lshl_add_u32 v8, v3, 4, v8
    v_add_u32 v8, s55, v8
    ds_write_b128 v7, v[128:131] offset:0
    ds_write_b128 v7, v[132:135] offset:1024
    ds_write_b128 v7, v[136:139] offset:2048
    ds_write_b128 v7, v[140:143] offset:3072
    ds_write_b128 v7, v[144:147] offset:4096
    ds_write_b128 v7, v[148:151] offset:5120
    ds_write_b128 v7, v[152:155] offset:6144
    ds_write_b128 v7, v[156:159] offset:7168
    s_waitcnt lgkmcnt(0)
    s_barrier
    ds_read_b128 v[64:67], v8 offset:0
    ds_read_b128 v[68:71], v8 offset:512
    ds_read_b128 v[72:75], v8 offset:8192
    ds_read_b128 v[76:79], v8 offset:8704
    ds_read_b128 v[80:83], v8 offset:16384
    ds_read_b128 v[84:87], v8 offset:16896
    ds_read_b128 v[88:91], v8 offset:24576
    ds_read_b128 v[92:95], v8 offset:25088
    s_waitcnt lgkmcnt(6)
    v_add_f32 v64, v64, v68
    v_add_f32 v65, v65, v69
    v_add_f32 v66, v66, v70
    v_add_f32 v67, v67, v71
    s_waitcnt lgkmcnt(4)
    v_add_f32 v72, v72, v76
    v_add_f32 v73, v73, v77
    v_add_f32 v74, v74, v78
    v_add_f32 v75, v75, v79
    s_waitcnt lgkmcnt(2)
    v_add_f32 v80, v80, v84
    v_add_f32 v81, v81, v85
    v_add_f32 v82, v82, v86
    v_add_f32 v83, v83, v87
    v_add_f32 v64, v64, v72
    v_add_f32 v65, v65, v73
    v_add_f32 v66, v66, v74
    v_add_f32 v67, v67, v75
    s_waitcnt lgkmcnt(0)
    v_add_f32 v88, v88, v92
    v_add_f32 v89, v89, v93
    v_add_f32 v90, v90, v94
    v_add_f32 v91, v91, v95
    v_add_f32 v80, v80, v88
    v_add_f32 v81, v81, v89
    v_add_f32 v82, v82, v90
    v_add_f32 v83, v83, v91
    v_add_f32 v64, v64, v80
    v_add_f32 v65, v65, v81
    v_add_f32 v66, v66, v82
    v_add_f32 v67, v67, v83
    v_min_u32 v64, -2, v64
    v_min_u32 v65, -2, v65
    v_min_u32 v66, -2, v66
    v_min_u32 v67, -2, v67
    buffer_store_dwordx4 v[64:67], v12, s[40:43], s60 offen sc1
    s_cmp_lg_u32 s31, 0
    s_cbranch_scc1 L_end
    s_and_b32 s55, s2, 1
    s_lshl_b32 s56, s4, 1
    s_add_u32 s56, s56, s55
    s_lshl_b32 s56, s56, 18
    s_bfe_u32 s57, s2, 0x60001
    s_lshl_b32 s58, s57, 12
    s_add_u32 s56, s56, s58
    s_add_u32 s56, s56, 2097152
    s_mov_b32 s44, s20
    s_mov_b32 s45, s21
    s_mov_b32 s46, 16384
    s_mov_b32 s47, 0x20000
    s_lshl_b32 s58, s55, 13
    s_lshl_b32 s59, s4, 10
    s_add_u32 s58, s58, s59
    s_lshl_b32 s59, s57, 4
    s_add_u32 s58, s58, s59
    v_lshlrev_b32 v8, 1, v0
Lp_30:
    buffer_load_dwordx4 v[16:19], v5, s[40:43], s56 offen offset:0 sc1
    buffer_load_dwordx4 v[20:23], v5, s[40:43], s56 offen offset:1024 sc1
    buffer_load_dwordx4 v[24:27], v5, s[40:43], s56 offen offset:2048 sc1
    buffer_load_dwordx4 v[28:31], v5, s[40:43], s56 offen offset:3072 sc1
    s_waitcnt vmcnt(0)
    v_max3_u32 v32, v16, v17, v18
    v_max3_u32 v33, v19, v20, v21
    v_max3_u32 v32, v32, v22, v23
    v_max3_u32 v33, v33, v24, v25
    v_max3_u32 v32, v32, v26, v27
    v_max3_u32 v33, v33, v28, v29
    v_max3_u32 v32, v32, v30, v31
    v_max_u32 v32, v32, v33
    v_cmp_eq_u32 vcc, -1, v32
    s_mov_b64 exec, vcc
    s_cbranch_execz Ld_31
    s_sub_u32 s52, s52, 1
    s_cbranch_scc1 L_end
    s_sleep 2
    s_branch Lp_30
Ld_31:
    s_mov_b64 exec, -1
    v_add_f32 v16, v16, v20
    v_add_f32 v17, v17, v21
    v_add_f32 v18, v18, v22
    v_add_f32 v19, v19, v23
    v_add_f32 v24, v24, v28
    v_add_f32 v25, v25, v29
    v_add_f32 v26, v26, v30
    v_add_f32 v27, v27, v31
    v_add_f32 v16, v16, v24
    v_add_f32 v17, v17, v25
    v_add_f32 v18, v18, v26
    v_add_f32 v19, v19, v27
    s_nop 1
    v_add_f32_dpp v20, v16, v16 row_ror:8 row_mask:0xf bank_mask:0xf
    v_add_f32_dpp v21, v17, v17 row_ror:8 row_mask:0xf bank_mask:0xf
    v_add_f32_dpp v22, v18, v18 row_ror:8 row_mask:0xf bank_mask:0xf
    v_add_f32_dpp v23, v19, v19 row_ror:8 row_mask:0xf bank_mask:0xf
    v_mov_b32 v24, v20
    v_mov_b32 v25, v21
    v_mov_b32 v26, v22
    v_mov_b32 v27, v23
    s_nop 1
    v_permlane32_swap_b32 v20, v24
    v_permlane32_swap_b32 v21, v25
    v_permlane32_swap_b32 v22, v26
    v_permlane32_swap_b32 v23, v27
    s_nop 1
    v_add_f32 v20, v20, v24
    v_add_f32 v21, v21, v25
    v_add_f32 v22, v22, v26
    v_add_f32 v23, v23, v27
    v_mov_b32 v24, v20
    v_mov_b32 v25, v21
    v_mov_b32 v26, v22
    v_mov_b32 v27, v23
    s_nop 1
    v_permlane16_swap_b32 v20, v24
    v_permlane16_swap_b32 v21, v25
    v_permlane16_swap_b32 v22, v26
    v_permlane16_swap_b32 v23, v27
    s_nop 1
    v_add_f32 v20, v20, v24
    v_add_f32 v21, v21, v25
    v_add_f32 v22, v22, v26
    v_add_f32 v23, v23, v27
    v_cvt_pk_bf16_f32 v20, v20, v20
    v_cvt_pk_bf16_f32 v21, v21, v21
    v_cvt_pk_bf16_f32 v22, v22, v22
    v_cvt_pk_bf16_f32 v23, v23, v23
    s_mov_b64 exec, 0xff
    s_add_u32 s59, s58, 4096
    buffer_store_short v20, v8, s[44:47], s58 offen offset:0
    buffer_store_short v21, v8, s[44:47], s58 offen offset:2048
    buffer_store_short v22, v8, s[44:47], s59 offen offset:0
    buffer_store_short v23, v8, s[44:47], s59 offen offset:2048
    s_and_b32 s55, s2, 127
    s_cmp_lg_u32 s55, 0
    s_cbranch_scc1 Lf_32
    s_mov_b64 exec, 1
    v_mov_b32 v24, s50
    v_mov_b32 v25, s51
    v_mov_b32 v26, 0
    s_lshl_b32 s58, s4, 7
    buffer_store_dwordx2 v[24:25], v26, s[40:43], s58 offen sc1
Lf_32:
L_end:
    s_endpgm
L_code_end:
.section .rodata,"a"
.p2align 6
.amdhsa_kernel concat_heads__sliding_block_cached__sliding_block_cached__decode_kernel
  .amdhsa_next_free_vgpr 256
  .amdhsa_next_free_sgpr 102
  .amdhsa_accum_offset 256
  .amdhsa_group_segment_fixed_size 0
  .amdhsa_kernarg_size 104
  .amdhsa_user_sgpr_count 2
  .amdhsa_user_sgpr_kernarg_segment_ptr 1
  .amdhsa_system_sgpr_workgroup_id_x 1
.end_amdhsa_kernel
```
